```python
import torch

def _softmax(x, axis=-1):
    return torch.softmax(x, dim=axis)
def _gelu(x):
    return torch.nn.functional.gelu(x, approximate="tanh")
def _silu(x):
    return torch.nn.functional.silu(x)
def _sigmoid(x):
    return torch.sigmoid(x)
def _layernorm(x, axis=-1, eps=1e-5):
    m = x.mean(dim=axis, keepdim=True)
    v = x.var(dim=axis, keepdim=True, unbiased=False)
    return (x - m) / torch.sqrt(v + eps)
def _scatter_add(tgt, idx, src, axis=0):
    return tgt.clone().index_add_(axis, idx, src)
def _segment_sum(src, seg, n):
    out = torch.zeros((n,) + src.shape[1:], dtype=src.dtype)
    return out.index_add_(0, seg, src)
def _pad(x, pw):
    flat = tuple(v for pair in reversed(pw) for v in pair)
    return torch.nn.functional.pad(x, flat)

kernel_name = 'standalone__paged_block_table_kv_pagedattention__sampling'

def setup_inputs():

    _w = (lambda a: (lambda t: t.to(torch.bfloat16) if t.is_floating_point() else t)(torch.as_tensor(a)))
    B, Hq, Hkv, Sq, Skv, D = 16, 32, 8, 16, 4096, 128
    bs = 16
    nbps = max(1, Skv // bs)
    num_phys = B * nbps + 4
    bt = torch.randperm(num_phys)[: B * nbps].reshape(B, nbps).to(torch.int64)
    cl = (nbps * bs - (torch.arange(1, B + 1, dtype=torch.int64) * 2654435761) % max(1, nbps * bs // 2)).to(torch.int64)
    return {
        "q": _w((lambda *s: torch.randn(*s, dtype=torch.bfloat16) * 0.8)(B, Hq, Sq, D)),
        "k_cache": _w((lambda *s: torch.randn(*s, dtype=torch.bfloat16) * 0.8)(num_phys, bs, Hkv, D)),
        "v_cache": _w((lambda *s: torch.randn(*s, dtype=torch.bfloat16) * 0.05)(num_phys, bs, Hkv, D)),
        "block_table": _w(bt),
        "context_lens": _w(cl),
    }

def reference(q, k_cache, v_cache, block_table, context_lens):
    B, Hq, Sq, D = q.shape
    bs = k_cache.shape[1]
    Hkv = k_cache.shape[2]
    nbps = block_table.shape[1]
    Skv = nbps * bs
    bt = block_table.reshape(-1)
    k = (lambda x, *d: x.permute(*d))(k_cache[bt].reshape(B, Skv, Hkv, D), 0, 2, 1, 3)
    v = (lambda x, *d: x.permute(*d))(v_cache[bt].reshape(B, Skv, Hkv, D), 0, 2, 1, 3)
    g = Hq // Hkv
    qg = q.reshape(B, Hkv, g, Sq, D)
    scores = torch.einsum("bhgqd,bhkd->bhgqk", qg, k) * (D ** -0.5)
    pos = torch.arange(Skv)
    msk = pos[None, :] < context_lens[:, None]
    scores = torch.where(msk[:, None, None, None, :], scores, -1e9)
    p = _softmax(scores, axis=-1)
    out = torch.einsum("bhgqk,bhkd->bhgqd", p, v)
    return out.reshape(B, Hq, Sq, D)
```

```asm
; @launch grid=(256,1,1) block=(448,1,1) lds=149824
.amdgcn_target "amdgcn-amd-amdhsa--gfx950"
.text
.globl standalone__paged_block_table_kv_pagedattention__sampling_kernel
.p2align 12
.p2align 8
.type standalone__paged_block_table_kv_pagedattention__sampling_kernel,@function
standalone__paged_block_table_kv_pagedattention__sampling_kernel:
  s_cmp_ge_u32 s2, 256
  s_cbranch_scc1 L_END
  s_load_dwordx16 s[4:19], s[0:1], 0
  v_lshrrev_b32 v1, 6, v0
  v_and_b32 v2, 63, v0
  s_lshr_b32 s20, s2, 3
  v_readfirstlane_b32 s3, v1
  s_and_b32 s20, s20, 1
  s_lshr_b32 s21, s2, 4
  s_and_b32 s22, s2, 7
  v_and_b32 v3, 15, v2
  v_lshrrev_b32 v4, 4, v2
  s_cmp_lt_u32 s3, 4
  s_cbranch_scc1 L_COMPUTE
  s_cmp_lt_u32 s3, 6
  s_cbranch_scc0 S_START
L_LOADER:
  s_sub_u32 s23, s3, 4
  v_lshlrev_b32 v5, s23, v4
  v_xor_b32 v5, v5, v3
  v_lshlrev_b32 v5, 4, v5
  v_lshl_add_u32 v8, v4, 11, v5
  s_cmp_eq_u32 s23, 0
  s_movk_i32 s50, 128
  s_cmovk_i32 s50, 64
  v_xor_b32 v5, s50, v8
  v_add_u32 v9, 7168, v5
  s_movk_i32 s50, 0
  s_cmovk_i32 s50, 128
  v_xor_b32 v5, s50, v8
  v_add_u32 v10, 14336, v5
  s_movk_i32 s50, 128
  s_cmovk_i32 s50, 192
  v_xor_b32 v5, s50, v8
  v_add_u32 v11, 21504, v5
  s_lshl_b32 s40, s23, 14
  v_mov_b32 v17, 147456
  s_lshl_b32 s41, s23, 2
  s_add_u32 s41, s41, 149760
  v_mov_b32 v25, s41
  v_mov_b32 v32, 149760
  s_mov_b32 s43, 0
  s_mov_b32 s46, 0
  s_lshl_b32 s48, s21, 10
  s_lshl_b32 s49, s22, 8
  s_mov_b32 m0, s40
  s_waitcnt lgkmcnt(0)
  s_cmp_eq_u32 s20, 0
  s_cbranch_scc0 L_NOBT
  s_load_dwordx4 s[52:55], s[10:11], s48
L_NOBT:
  s_cmp_eq_u32 s23, 0
  s_cselect_b32 s6, s6, s8
  s_cselect_b32 s7, s7, s9
  s_mov_b32 s24, s6
  s_and_b32 s25, s7, 0xffff
  s_mov_b32 s26, 134348800
  s_mov_b32 s27, 0x20000
  s_cmp_eq_u32 s20, 0
  s_cbranch_scc0 L_BINIT
  s_mov_b32 s46, 1
  s_waitcnt lgkmcnt(0)
  s_lshl_b32 s50, s52, 15
  s_add_u32 s50, s50, s49
  s_nop 0
  buffer_load_dwordx4 v8, s[24:27], s50 offen offset:0 nt lds
  buffer_load_dwordx4 v9, s[24:27], s50 offen offset:1024 nt lds
  buffer_load_dwordx4 v10, s[24:27], s50 offen offset:2048 nt lds
  buffer_load_dwordx4 v11, s[24:27], s50 offen offset:3072 nt lds
  s_lshl_b32 s50, s53, 15
  s_add_u32 s50, s50, s49
  s_add_u32 m0, s40, 4096
  s_nop 0
  buffer_load_dwordx4 v8, s[24:27], s50 offen offset:0 nt lds
  buffer_load_dwordx4 v9, s[24:27], s50 offen offset:1024 nt lds
  buffer_load_dwordx4 v10, s[24:27], s50 offen offset:2048 nt lds
  buffer_load_dwordx4 v11, s[24:27], s50 offen offset:3072 nt lds
  s_lshl_b32 s50, s54, 15
  s_add_u32 s50, s50, s49
  s_add_u32 m0, s40, 8192
  s_nop 0
  buffer_load_dwordx4 v8, s[24:27], s50 offen offset:0 nt lds
  buffer_load_dwordx4 v9, s[24:27], s50 offen offset:1024 nt lds
  buffer_load_dwordx4 v10, s[24:27], s50 offen offset:2048 nt lds
  s_waitcnt vmcnt(10)
  buffer_load_dwordx4 v11, s[24:27], s50 offen offset:3072 nt lds
  s_lshl_b32 s50, s55, 15
  s_add_u32 s50, s50, s49
  s_add_u32 m0, s40, 12288
  s_waitcnt vmcnt(10)
  buffer_load_dwordx4 v8, s[24:27], s50 offen offset:0 nt lds
  s_waitcnt vmcnt(10)
  buffer_load_dwordx4 v9, s[24:27], s50 offen offset:1024 nt lds
  s_waitcnt vmcnt(10)
  buffer_load_dwordx4 v10, s[24:27], s50 offen offset:2048 nt lds
  s_waitcnt vmcnt(10)
  buffer_load_dwordx4 v11, s[24:27], s50 offen offset:3072 nt lds
L_BINIT:
  s_barrier
  s_branch L_SLOW1
S_START:
  v_lshlrev_b32 v5, 4, v2
  v_lshlrev_b32 v15, 2, v3
  s_lshl_b32 s57, s21, 10
  s_add_u32 m0, s57, 131072
  s_lshl_b32 s46, s22, 8
  s_waitcnt lgkmcnt(0)
  s_mov_b32 s24, s10
  s_and_b32 s25, s11, 0xffff
  s_mov_b32 s26, 16384
  s_mov_b32 s27, 0x20000
  s_mov_b32 s28, s12
  s_and_b32 s29, s13, 0xffff
  s_mov_b32 s30, 64
  s_mov_b32 s31, 0x20000
  buffer_load_dword v6, v15, s[28:31], 0 offen
  s_cmp_eq_u32 s20, 0
  s_cbranch_scc0 S_ALLROWS
  buffer_load_dwordx4 v5, s[24:27], s57 offen  lds
  s_branch S_ROWS
S_ALLROWS:
  s_mov_b32 m0, 131072
  s_mov_b32 s57, 0
  buffer_load_dwordx4 v5, s[24:27], s57 offen offset:0  lds
  buffer_load_dwordx4 v5, s[24:27], s57 offen offset:1024  lds
  buffer_load_dwordx4 v5, s[24:27], s57 offen offset:2048  lds
  buffer_load_dwordx4 v5, s[24:27], s57 offen offset:3072  lds
  s_mov_b32 m0, 135168
  s_mov_b32 s57, 4096
  buffer_load_dwordx4 v5, s[24:27], s57 offen offset:0  lds
  buffer_load_dwordx4 v5, s[24:27], s57 offen offset:1024  lds
  buffer_load_dwordx4 v5, s[24:27], s57 offen offset:2048  lds
  buffer_load_dwordx4 v5, s[24:27], s57 offen offset:3072  lds
  s_mov_b32 m0, 139264
  s_mov_b32 s57, 8192
  buffer_load_dwordx4 v5, s[24:27], s57 offen offset:0  lds
  buffer_load_dwordx4 v5, s[24:27], s57 offen offset:1024  lds
  buffer_load_dwordx4 v5, s[24:27], s57 offen offset:2048  lds
  buffer_load_dwordx4 v5, s[24:27], s57 offen offset:3072  lds
  s_mov_b32 m0, 143360
  s_mov_b32 s57, 12288
  buffer_load_dwordx4 v5, s[24:27], s57 offen offset:0  lds
  buffer_load_dwordx4 v5, s[24:27], s57 offen offset:1024  lds
  buffer_load_dwordx4 v5, s[24:27], s57 offen offset:2048  lds
  buffer_load_dwordx4 v5, s[24:27], s57 offen offset:3072  lds
S_ROWS:
  v_and_b32 v19, 3, v2
  v_and_b32 v23, 7, v2
  v_mov_b32 v22, 268435456
  v_mov_b32 v21, 0
  v_add_u32 v18, 149760, v15
  ds_write_b32 v18, v21
  v_lshrrev_b32 v24, 3, v2
  v_lshlrev_b32 v25, 2, v2
  v_add_u32 v25, 147456, v25
  v_mov_b32 v26, 149768
  s_mov_b32 s41, 0
  s_mov_b32 s58, 4096
  s_mov_b32 s47, 0
  s_mov_b32 s50, 0
  s_mov_b32 s45, 0
  s_mov_b32 s44, 0
  s_cmp_eq_u32 s20, 0
  s_cbranch_scc0 S_WCL
  s_waitcnt vmcnt(1)
  s_branch S_PLAN
S_WCL:
  s_waitcnt vmcnt(16)
S_PLAN:
  v_max_i32 v7, 0, v6
  v_min_i32 v7, s58, v7
  v_cmp_gt_i32 vcc, 1, v6
  v_mov_b32 v15, s58
  s_nop 0
  v_cndmask_b32 v15, v7, v15, vcc
  v_add_u32 v8, 15, v15
  v_lshrrev_b32 v8, 4, v8
  v_add_u32 v9, 63, v15
  v_lshrrev_b32 v9, 6, v9
  v_mov_b32 v12, v9
  s_nop 1
  v_add_u32_dpp v12, v12, v12 row_shr:1 row_mask:0xf bank_mask:0xf bound_ctrl:0
  s_nop 1
  v_add_u32_dpp v12, v12, v12 row_shr:2 row_mask:0xf bank_mask:0xf bound_ctrl:0
  s_nop 1
  v_add_u32_dpp v12, v12, v12 row_shr:4 row_mask:0xf bank_mask:0xf bound_ctrl:0
  s_nop 1
  v_add_u32_dpp v12, v12, v12 row_shr:8 row_mask:0xf bank_mask:0xf bound_ctrl:0
  s_nop 0
  v_readlane_b32 s56, v12, 15
  s_add_u32 s56, s56, 95
  s_lshr_b32 s56, s56, 5
  s_nop 0
  v_min_u32 v10, s56, v9
  v_sub_u32 v11, v9, v10
  v_mov_b32 v12, v11
  s_nop 1
  v_add_u32_dpp v12, v12, v12 row_shr:1 row_mask:0xf bank_mask:0xf bound_ctrl:0
  s_nop 1
  v_add_u32_dpp v12, v12, v12 row_shr:2 row_mask:0xf bank_mask:0xf bound_ctrl:0
  s_nop 1
  v_add_u32_dpp v12, v12, v12 row_shr:4 row_mask:0xf bank_mask:0xf bound_ctrl:0
  s_nop 1
  v_add_u32_dpp v12, v12, v12 row_shr:8 row_mask:0xf bank_mask:0xf bound_ctrl:0
  s_nop 0
  v_readlane_b32 s48, v12, 15
  s_cmp_eq_u32 s20, 0
  s_cbranch_scc0 S_HPLAN
  v_readlane_b32 s57, v12, s21
  v_readlane_b32 s58, v11, s21
  v_readlane_b32 s38, v10, s21
  v_mul_u32_u24 v15, s48, v3
  v_add_u32 v16, s48, v15
  v_lshrrev_b32 v15, 4, v15
  v_lshrrev_b32 v16, 4, v16
  s_sub_u32 s58, s57, s58
  v_min_u32 v16, s57, v16
  v_max_u32 v15, s58, v15
  v_cmp_lt_u32 vcc, v15, v16
  s_mov_b32 s36, s21
  s_mov_b32 s37, 0
  s_mov_b32 s39, 0
  s_and_b32 s45, vcc_lo, 0xffff
  s_lshl_b32 s45, s45, 16
  s_branch S_SEG
S_HPLAN:
  s_mul_i32 s56, s48, s21
  s_add_u32 s57, s56, s48
  s_lshr_b32 s56, s56, 4
  s_lshr_b32 s57, s57, 4
  v_sub_u32 v15, v12, v11
  v_max_u32 v16, s56, v15
  v_min_u32 v17, s57, v12
  v_cmp_lt_u32 vcc, v16, v17
  v_sub_u32 v14, v17, v16
  v_sub_u32 v13, v16, v15
  v_add_u32 v13, v13, v10
  s_and_b32 s39, vcc_lo, 0xffff
S_NEXT:
  s_cmp_eq_u32 s39, 0
  s_cbranch_scc1 S_STOP
  s_ff1_i32_b32 s36, s39
  s_bitset0_b32 s39, s36
  s_mov_b32 s45, s21
  v_readlane_b32 s38, v14, s36
  v_readlane_b32 s37, v13, s36
S_SEG:
  v_readlane_b32 s42, v8, s36
  v_readlane_b32 s43, v7, s36
  s_lshl_b32 s56, s36, 3
  s_add_u32 s56, s56, s22
  s_lshl_b32 s44, s56, 2
  s_lshl_b32 s57, s56, 16
  s_or_b32 s44, s44, s57
  s_lshl_b32 s56, s56, 4
  s_add_u32 s45, s45, s56
  s_lshl_b32 s40, s47, 2
  s_or_b32 s40, s40, 2
  s_mov_b32 s47, s20
  s_lshl_b32 s49, s36, 10
  s_add_u32 s49, s49, 131072
  v_cmp_eq_u32 vcc, 1, v23
  v_mov_b32 v18, s45
  v_mov_b32 v11, s44
  v_cndmask_b32 v11, v18, v11, vcc
  s_ff1_i32_b32 s56, s39
  s_lshl_b32 s56, s56, 3
  s_add_u32 s56, s56, s22
  s_mul_i32 s51, s56, 0x10004
  s_mov_b32 s52, 0
  s_waitcnt vmcnt(0)
S_PASS:
  v_add_u32 v16, s37, v24
  v_lshl_add_u32 v17, v16, 2, v19
  v_and_b32 v17, 255, v17
  v_lshl_add_u32 v18, v17, 2, s49
  ds_read_b32 v20, v18
  v_cmp_gt_u32 s[58:59], s42, v17
  v_lshlrev_b32 v16, 6, v16
  v_sub_u32 v16, s43, v16
  v_sub_u32 v15, s38, v24
  v_cmp_gt_i32 vcc, 64, v16
  v_mov_b32 v17, 1
  v_mov_b32 v18, 9
  v_cndmask_b32 v17, v17, v18, vcc
  v_cmp_eq_u32 vcc, 0, v24
  v_or_b32 v18, s40, v17
  s_mov_b32 s40, 0
  v_cndmask_b32 v17, v17, v18, vcc
  s_cmp_eq_u32 s20, 0
  s_cbranch_scc1 S_OWFL
  s_cmp_eq_u32 s39, 0
  s_cbranch_scc1 S_NOFL
S_QPFL:
  v_add_u32 v18, s52, v24
  v_cmp_eq_u32 vcc, 2, v15
  v_cmp_lt_u32 s[62:63], 0, v18
  v_or_b32 v18, 512, v17
  s_and_b64 vcc, vcc, s[62:63]
  v_cndmask_b32 v17, v17, v18, vcc
  v_cmp_eq_u32 s[62:63], 3, v23
  v_mov_b32 v18, s51
  s_and_b64 vcc, vcc, s[62:63]
  v_cndmask_b32 v27, v11, v18, vcc
  s_branch S_NOFL2
S_OWFL:
  v_cmp_ge_i32 vcc, 3, v15
  v_or_b32 v18, 16, v17
  s_nop 0
  v_cndmask_b32 v17, v17, v18, vcc
  v_cmp_ge_i32 vcc, 4, v15
  v_or_b32 v18, 128, v17
  s_nop 0
  v_cndmask_b32 v17, v17, v18, vcc
  v_cmp_ge_i32 vcc, 1, v15
  v_or_b32 v18, 32, v17
  s_nop 0
  v_cndmask_b32 v17, v17, v18, vcc
S_NOFL:
  v_mov_b32 v27, v11
S_NOFL2:
  v_cmp_eq_u32 vcc, 2, v23
  v_and_b32 v18, 1, v23
  v_cmp_eq_u32 s[62:63], 1, v18
  v_cndmask_b32 v17, v17, v16, vcc
  v_cmp_gt_u32 vcc, 4, v23
  v_cndmask_b32 v17, v17, v27, s[62:63]
  v_cmp_lt_i32 s[62:63], 0, v15
  s_min_u32 s57, s38, 8
  s_add_u32 s41, s41, s57
  v_mov_b32 v18, s41
  s_waitcnt lgkmcnt(0)
  v_lshlrev_b32 v20, 15, v20
  v_add_u32 v20, s46, v20
  v_cndmask_b32 v20, v22, v20, s[58:59]
  v_cndmask_b32 v20, v20, v17, vcc
  s_mov_b64 exec, s[62:63]
  ds_write_b32 v25, v20
  s_mov_b64 exec, 1
  ds_write_b32 v26, v18
  s_mov_b64 exec, -1
  s_lshl_b32 s56, s57, 5
  v_add_u32 v25, s56, v25
  s_add_u32 s37, s37, s57
  s_sub_u32 s38, s38, s57
  s_mov_b32 s52, 8
  s_cmp_lg_u32 s50, 0
  s_cbranch_scc1 S_NOBAR
  s_mov_b32 s50, 1
  s_waitcnt lgkmcnt(0)
  s_barrier
S_NOBAR:
  s_cmp_lg_u32 s38, 0
  s_cbranch_scc1 S_PASS
  s_branch S_NEXT
L_COMPUTE:
  v_xor_b32 v5, v4, v3
  v_lshlrev_b32 v176, 8, v3
  v_lshl_add_u32 v176, v5, 4, v176
  v_xor_b32 v177, 64, v176
  v_xor_b32 v178, 128, v176
  v_xor_b32 v179, 192, v176
  v_lshrrev_b32 v5, 2, v2
  v_and_b32 v6, 7, v5
  v_and_b32 v7, 3, v2
  v_lshlrev_b32 v180, 8, v5
  v_lshl_add_u32 v180, v6, 5, v180
  v_lshl_add_u32 v180, v7, 3, v180
  v_xor_b32 v181, 32, v180
  v_xor_b32 v182, 64, v180
  v_xor_b32 v183, 96, v180
  v_xor_b32 v184, 128, v180
  v_xor_b32 v185, 160, v180
  v_xor_b32 v186, 192, v180
  v_xor_b32 v187, 224, v180
  v_mov_b32 v244, 0x3f803f80
  v_mov_b32 v245, 0x3f803f80
  v_mov_b32 v246, 0x3f803f80
  v_mov_b32 v247, 0x3f803f80
  v_mov_b32 v254, 147456
  s_mov_b32 s40, 0x3e0293ee
  s_mov_b32 s43, 0x80000000
  s_lshl_b32 s61, s3, 12
  s_mul_i32 s62, s3, 4608
  s_mov_b32 s63, 0
  s_mov_b32 s58, 0
  s_mov_b32 s42, 0xfffe8000
  s_mov_b32 s54, 0
  s_mov_b32 s55, 0
  s_mov_b32 s56, 0
  s_mov_b32 s57, 0
  s_mov_b32 s59, 0
  s_mov_b32 s60, 0
  s_mov_b32 s66, 0
  s_mov_b32 s74, 0
  s_mov_b32 s79, 149792
  v_mov_b32 v255, 149760
  s_mov_b32 s75, 0
  s_mov_b32 s76, -1
  s_lshl_b32 s68, s21, 3
  s_add_u32 s68, s68, s22
  s_lshl_b32 s52, s68, 2
  s_lshl_b32 s68, s68, 16
  s_or_b32 s52, s52, s68
  s_waitcnt lgkmcnt(0)
  s_mov_b32 s24, s4
  s_and_b32 s25, s5, 0xffff
  s_mov_b32 s26, 2097152
  s_mov_b32 s27, 0x20000
  s_mov_b32 s28, s14
  s_and_b32 s29, s15, 0xffff
  s_mov_b32 s30, 2097152
  s_mov_b32 s31, 0x20000
  s_mov_b32 s36, s18
  s_and_b32 s37, s19, 0xffff
  s_mov_b32 s38, 537395200
  s_mov_b32 s39, 0x20000
  s_cmp_eq_u32 s20, 0
  s_cselect_b32 s52, s52, -2
  s_cbranch_scc0 C_NOQ
  s_and_b32 s68, s52, 0xffff
  s_lshl_b32 s68, s68, 12
  s_add_u32 s68, s68, s61
  v_mbcnt_lo_u32_b32 v248, -1, 0
  v_mbcnt_hi_u32_b32 v248, -1, v248
  v_and_b32 v249, 15, v248
  v_lshrrev_b32 v248, 4, v248
  v_lshlrev_b32 v249, 8, v249
  v_lshl_add_u32 v249, v248, 4, v249
  buffer_load_dwordx4 v[8:11], v249, s[24:27], s68 offen offset:0
  buffer_load_dwordx4 v[12:15], v249, s[24:27], s68 offen offset:64
  buffer_load_dwordx4 v[16:19], v249, s[24:27], s68 offen offset:128
  buffer_load_dwordx4 v[20:23], v249, s[24:27], s68 offen offset:192
C_NOQ:
  s_lshl_b32 s68, s3, 2
  s_add_u32 s68, s68, 149776
  v_mov_b32 v252, s68
  s_barrier
  ds_read_b64 v[4:5], v254
  s_waitcnt lgkmcnt(0)
  v_readfirstlane_b32 s48, v4
  v_readfirstlane_b32 s49, v5
  s_bitcmp1_b32 s48, 1
  s_cbranch_scc0 C_LOOP
  s_cmp_eq_u32 s49, s52
  s_cbranch_scc1 C_LOOP
  s_mov_b32 s52, s49
  s_and_b32 s68, s52, 0xffff
  s_lshl_b32 s68, s68, 12
  s_add_u32 s68, s68, s61
  v_mbcnt_lo_u32_b32 v248, -1, 0
  v_mbcnt_hi_u32_b32 v248, -1, v248
  v_and_b32 v249, 15, v248
  v_lshrrev_b32 v248, 4, v248
  v_lshlrev_b32 v249, 8, v249
  v_lshl_add_u32 v249, v248, 4, v249
  buffer_load_dwordx4 v[8:11], v249, s[24:27], s68 offen offset:0
  buffer_load_dwordx4 v[12:15], v249, s[24:27], s68 offen offset:64
  buffer_load_dwordx4 v[16:19], v249, s[24:27], s68 offen offset:128
  buffer_load_dwordx4 v[20:23], v249, s[24:27], s68 offen offset:192
  s_branch C_LOOP
L_SLOW:
  s_sleep 1
L_SLOW1:
  ds_read_b128 v[36:39], v32 offset:16
  ds_read_b32 v40, v32 offset:8
  ds_read_b128 v[20:23], v17 offset:16
  ds_read_b32 v24, v17
  s_waitcnt lgkmcnt(0)
  v_min_u32 v36, v36, v37
  v_min3_u32 v36, v36, v38, v39
  v_readfirstlane_b32 s44, v40
  v_readfirstlane_b32 s47, v24
  v_readfirstlane_b32 s45, v36
L_CHK:
  s_cmp_lt_u32 s43, s44
  s_cbranch_scc0 L_SLOW
  v_mov_b32 v33, s43
  s_bitcmp1_b32 s47, 11
  s_cbranch_scc1 L_TAIL
  s_add_u32 s45, s45, 4
  s_cmp_lt_u32 s43, s45
  s_cbranch_scc0 L_SLOW
  v_mov_b32 v12, v20
  v_mov_b32 v13, v21
  v_mov_b32 v14, v22
  v_mov_b32 v15, v23
  v_add_u32 v17, 32, v17
  s_mov_b32 s42, s47
  s_mov_b32 m0, s40
  s_add_u32 s43, s43, 1
  s_cmp_eq_u32 s46, 0
  s_cbranch_scc1 L_GO
  s_mov_b32 s46, 0
  s_add_u32 s40, s40, 32768
  s_branch L_SLOW1
L_GO:
  s_bitcmp1_b32 s42, 7
  s_cbranch_scc1 L_FAST
  v_add_u32 v18, v12, v8
  s_waitcnt vmcnt(10)
  buffer_load_dwordx4 v18, s[24:27], 0 offen offset:0 nt lds
  v_add_u32 v19, v12, v9
  s_waitcnt vmcnt(10)
  buffer_load_dwordx4 v19, s[24:27], 0 offen offset:1024 nt lds
  v_add_u32 v18, v12, v10
  s_waitcnt vmcnt(10)
  buffer_load_dwordx4 v18, s[24:27], 0 offen offset:2048 nt lds
  v_add_u32 v19, v12, v11
  s_waitcnt vmcnt(10)
  buffer_load_dwordx4 v19, s[24:27], 0 offen offset:3072 nt lds
  s_add_u32 m0, s40, 4096
  v_add_u32 v18, v13, v8
  s_waitcnt vmcnt(10)
  buffer_load_dwordx4 v18, s[24:27], 0 offen offset:0 nt lds
  v_add_u32 v19, v13, v9
  s_waitcnt vmcnt(10)
  buffer_load_dwordx4 v19, s[24:27], 0 offen offset:1024 nt lds
  v_add_u32 v18, v13, v10
  s_waitcnt vmcnt(10)
  buffer_load_dwordx4 v18, s[24:27], 0 offen offset:2048 nt lds
  v_add_u32 v19, v13, v11
  s_waitcnt vmcnt(10)
  buffer_load_dwordx4 v19, s[24:27], 0 offen offset:3072 nt lds
  s_add_u32 m0, s40, 8192
  v_add_u32 v18, v14, v8
  s_waitcnt vmcnt(10)
  buffer_load_dwordx4 v18, s[24:27], 0 offen offset:0 nt lds
  v_add_u32 v19, v14, v9
  s_waitcnt vmcnt(10)
  buffer_load_dwordx4 v19, s[24:27], 0 offen offset:1024 nt lds
  v_add_u32 v18, v14, v10
  s_waitcnt vmcnt(10)
  s_mov_b64 exec, 1
  ds_write_b32 v25, v33
  s_mov_b64 exec, -1
  buffer_load_dwordx4 v18, s[24:27], 0 offen offset:2048 nt lds
  v_add_u32 v19, v14, v11
  s_waitcnt vmcnt(10)
  buffer_load_dwordx4 v19, s[24:27], 0 offen offset:3072 nt lds
  s_add_u32 m0, s40, 12288
  v_add_u32 v18, v15, v8
  s_waitcnt vmcnt(10)
  buffer_load_dwordx4 v18, s[24:27], 0 offen offset:0 nt lds
  v_add_u32 v19, v15, v9
  s_waitcnt vmcnt(10)
  buffer_load_dwordx4 v19, s[24:27], 0 offen offset:1024 nt lds
  ds_read_b128 v[36:39], v32 offset:16
  ds_read_b32 v40, v32 offset:8
  ds_read_b128 v[20:23], v17 offset:16
  ds_read_b32 v24, v17
  v_add_u32 v18, v15, v10
  s_waitcnt vmcnt(10)
  buffer_load_dwordx4 v18, s[24:27], 0 offen offset:2048 nt lds
  v_add_u32 v19, v15, v11
  s_waitcnt vmcnt(10)
  buffer_load_dwordx4 v19, s[24:27], 0 offen offset:3072 nt lds
  s_branch L_ISSUED
L_FAST:
  v_add_u32 v18, v12, v8
  buffer_load_dwordx4 v18, s[24:27], 0 offen offset:0 nt lds
  v_add_u32 v19, v12, v9
  buffer_load_dwordx4 v19, s[24:27], 0 offen offset:1024 nt lds
  v_add_u32 v18, v12, v10
  buffer_load_dwordx4 v18, s[24:27], 0 offen offset:2048 nt lds
  v_add_u32 v19, v12, v11
  buffer_load_dwordx4 v19, s[24:27], 0 offen offset:3072 nt lds
  s_add_u32 m0, s40, 4096
  v_add_u32 v18, v13, v8
  buffer_load_dwordx4 v18, s[24:27], 0 offen offset:0 nt lds
  v_add_u32 v19, v13, v9
  buffer_load_dwordx4 v19, s[24:27], 0 offen offset:1024 nt lds
  v_add_u32 v18, v13, v10
  buffer_load_dwordx4 v18, s[24:27], 0 offen offset:2048 nt lds
  v_add_u32 v19, v13, v11
  buffer_load_dwordx4 v19, s[24:27], 0 offen offset:3072 nt lds
  s_add_u32 m0, s40, 8192
  v_add_u32 v18, v14, v8
  buffer_load_dwordx4 v18, s[24:27], 0 offen offset:0 nt lds
  v_add_u32 v19, v14, v9
  buffer_load_dwordx4 v19, s[24:27], 0 offen offset:1024 nt lds
  v_add_u32 v18, v14, v10
  buffer_load_dwordx4 v18, s[24:27], 0 offen offset:2048 nt lds
  v_add_u32 v19, v14, v11
  buffer_load_dwordx4 v19, s[24:27], 0 offen offset:3072 nt lds
  s_add_u32 m0, s40, 12288
  v_add_u32 v18, v15, v8
  buffer_load_dwordx4 v18, s[24:27], 0 offen offset:0 nt lds
  v_add_u32 v19, v15, v9
  buffer_load_dwordx4 v19, s[24:27], 0 offen offset:1024 nt lds
  ds_read_b128 v[36:39], v32 offset:16
  ds_read_b32 v40, v32 offset:8
  ds_read_b128 v[20:23], v17 offset:16
  ds_read_b32 v24, v17
  v_add_u32 v18, v15, v10
  buffer_load_dwordx4 v18, s[24:27], 0 offen offset:2048 nt lds
  v_add_u32 v19, v15, v11
  buffer_load_dwordx4 v19, s[24:27], 0 offen offset:3072 nt lds
  s_waitcnt vmcnt(16)
  s_mov_b64 exec, 1
  ds_write_b32 v25, v33
  s_mov_b64 exec, -1
  ds_read_b128 v[36:39], v32 offset:16
  ds_read_b32 v40, v32 offset:8
  ds_read_b128 v[20:23], v17 offset:16
  ds_read_b32 v24, v17
L_ISSUED:
  s_add_u32 s40, s40, 32768
  s_and_b32 s40, s40, 0x1ffff
  s_waitcnt lgkmcnt(0)
  v_min_u32 v36, v36, v37
  v_min3_u32 v36, v36, v38, v39
  v_readfirstlane_b32 s44, v40
  v_readfirstlane_b32 s47, v24
  v_readfirstlane_b32 s45, v36
  s_branch L_CHK
L_TAIL:
  v_add_u32 v33, 1, v33
  s_waitcnt vmcnt(0)
  s_mov_b64 exec, 1
  ds_write_b32 v25, v33
  s_mov_b64 exec, -1
  s_waitcnt lgkmcnt(0)
  s_endpgm
C_WAIT:
  s_sleep 1
C_LOOP:
  ds_read_b128 v[0:3], v255
  ds_read_b128 v[4:7], v254
  s_waitcnt lgkmcnt(1)
  v_min_u32 v249, v0, v1
  s_nop 0
  v_readfirstlane_b32 s68, v249
  s_cmp_lt_u32 s75, s68
  s_cbranch_scc0 C_WAIT
  ds_read_b128 v[80:83], v176 offset:0
  ds_read_b128 v[84:87], v177 offset:0
  ds_read_b128 v[88:91], v178 offset:0
  ds_read_b128 v[92:95], v179 offset:0
  ds_read_b128 v[96:99], v176 offset:4096
  ds_read_b128 v[100:103], v177 offset:4096
  ds_read_b128 v[104:107], v178 offset:4096
  ds_read_b128 v[108:111], v179 offset:4096
  ds_read_b128 v[112:115], v176 offset:8192
  ds_read_b128 v[116:119], v177 offset:8192
  ds_read_b128 v[120:123], v178 offset:8192
  ds_read_b128 v[124:127], v179 offset:8192
  ds_read_b128 v[128:131], v176 offset:12288
  ds_read_b128 v[132:135], v177 offset:12288
  ds_read_b128 v[136:139], v178 offset:12288
  ds_read_b128 v[140:143], v179 offset:12288
  s_waitcnt lgkmcnt(14)
C_GO:
  v_readfirstlane_b32 s44, v4
  s_add_u32 s75, s75, 1
  s_and_b32 s53, s75, 3
  s_cselect_b32 s41, 32768, s42
  s_and_b32 s68, s44, 838
  s_cbranch_scc1 C_SEG
C_CHK:
  s_waitcnt lgkmcnt(12)
  v_mfma_f32_16x16x32_bf16 v[56:59], v[80:83], v[8:11], 0
  ds_read_b64_tr_b16 v[144:145], v180 offset:16384
  v_mfma_f32_16x16x32_bf16 v[56:59], v[84:87], v[12:15], v[56:59]
  ds_read_b64_tr_b16 v[146:147], v180 offset:20480
  v_mfma_f32_16x16x32_bf16 v[56:59], v[88:91], v[16:19], v[56:59]
  ds_read_b64_tr_b16 v[148:149], v181 offset:16384
  v_mfma_f32_16x16x32_bf16 v[56:59], v[92:95], v[20:23], v[56:59]
  ds_read_b64_tr_b16 v[150:151], v181 offset:20480
  s_waitcnt lgkmcnt(12)
  v_mfma_f32_16x16x32_bf16 v[60:63], v[96:99], v[8:11], 0
  ds_read_b64_tr_b16 v[152:153], v182 offset:16384
  v_mfma_f32_16x16x32_bf16 v[60:63], v[100:103], v[12:15], v[60:63]
  ds_read_b64_tr_b16 v[154:155], v182 offset:20480
  v_mfma_f32_16x16x32_bf16 v[60:63], v[104:107], v[16:19], v[60:63]
  ds_read_b64_tr_b16 v[156:157], v183 offset:16384
  v_mfma_f32_16x16x32_bf16 v[60:63], v[108:111], v[20:23], v[60:63]
  ds_read_b64_tr_b16 v[158:159], v183 offset:20480
  s_waitcnt lgkmcnt(12)
  v_mfma_f32_16x16x32_bf16 v[64:67], v[112:115], v[8:11], 0
  ds_read_b64_tr_b16 v[160:161], v184 offset:16384
  v_mfma_f32_16x16x32_bf16 v[64:67], v[116:119], v[12:15], v[64:67]
  ds_read_b64_tr_b16 v[162:163], v184 offset:20480
  v_mfma_f32_16x16x32_bf16 v[64:67], v[120:123], v[16:19], v[64:67]
  ds_read_b64_tr_b16 v[164:165], v185 offset:16384
  v_mfma_f32_16x16x32_bf16 v[64:67], v[124:127], v[20:23], v[64:67]
  ds_read_b64_tr_b16 v[166:167], v185 offset:20480
  s_waitcnt lgkmcnt(12)
  v_mfma_f32_16x16x32_bf16 v[68:71], v[128:131], v[8:11], 0
  ds_read_b64_tr_b16 v[168:169], v186 offset:16384
  v_mfma_f32_16x16x32_bf16 v[68:71], v[132:135], v[12:15], v[68:71]
  ds_read_b64_tr_b16 v[170:171], v186 offset:20480
  v_mfma_f32_16x16x32_bf16 v[68:71], v[136:139], v[16:19], v[68:71]
  ds_read_b64_tr_b16 v[172:173], v187 offset:16384
  v_mfma_f32_16x16x32_bf16 v[68:71], v[140:143], v[20:23], v[68:71]
  ds_read_b64_tr_b16 v[174:175], v187 offset:20480
  v_add_u32 v176, s41, v176
  ds_read_b64_tr_b16 v[112:113], v180 offset:24576
  v_add_u32 v177, s41, v177
  ds_read_b64_tr_b16 v[114:115], v180 offset:28672
  v_add_u32 v178, s41, v178
  ds_read_b64_tr_b16 v[116:117], v181 offset:24576
  v_add_u32 v179, s41, v179
  ds_read_b64_tr_b16 v[118:119], v181 offset:28672
  s_bitcmp1_b32 s44, 3
  s_cbranch_scc1 C_MASK
C_MASKED:
  v_max3_f32 v248, v56, v57, v58
  ds_read_b64_tr_b16 v[120:121], v182 offset:24576
  v_max3_f32 v249, v59, v60, v61
  ds_read_b64_tr_b16 v[122:123], v182 offset:28672
  v_max3_f32 v248, v248, v62, v63
  ds_read_b64_tr_b16 v[124:125], v183 offset:24576
  v_max3_f32 v249, v249, v64, v65
  ds_read_b64_tr_b16 v[126:127], v183 offset:28672
  v_max3_f32 v248, v248, v66, v67
  ds_read_b64_tr_b16 v[128:129], v184 offset:24576
  v_max3_f32 v249, v249, v68, v69
  ds_read_b64_tr_b16 v[130:131], v184 offset:28672
  v_max3_f32 v248, v248, v70, v71
  v_max_f32 v248, v248, v249
  v_sub_f32 v250, v253, v248
  v_cmp_gt_f32 vcc, s43, v250
  v_add_u32 v254, 32, v254
  s_cbranch_vccnz C_RESC
C_NORESC:
  v_mov_b32 v248, s75
  v_fma_f32 v56, v56, s40, -v251
  v_fma_f32 v57, v57, s40, -v251
  ds_read_b64_tr_b16 v[132:133], v185 offset:24576
  v_fma_f32 v58, v58, s40, -v251
  v_fma_f32 v59, v59, s40, -v251
  ds_read_b64_tr_b16 v[134:135], v185 offset:28672
  v_exp_f32 v56, v56
  v_exp_f32 v57, v57
  ds_read_b64_tr_b16 v[136:137], v186 offset:24576
  v_exp_f32 v58, v58
  v_exp_f32 v59, v59
  ds_read_b64_tr_b16 v[138:139], v186 offset:28672
  v_fma_f32 v60, v60, s40, -v251
  v_fma_f32 v61, v61, s40, -v251
  ds_read_b64_tr_b16 v[140:141], v187 offset:24576
  v_fma_f32 v62, v62, s40, -v251
  v_fma_f32 v63, v63, s40, -v251
  ds_read_b64_tr_b16 v[142:143], v187 offset:28672
  v_exp_f32 v60, v60
  v_exp_f32 v61, v61
  v_exp_f32 v62, v62
  v_exp_f32 v63, v63
  v_cvt_pk_bf16_f32 v72, v56, v57
  v_cvt_pk_bf16_f32 v73, v58, v59
  ds_read_b128 v[0:3], v255
  ds_read_b128 v[4:7], v254
  v_cvt_pk_bf16_f32 v74, v60, v61
  v_cvt_pk_bf16_f32 v75, v62, v63
  v_fma_f32 v64, v64, s40, -v251
  s_waitcnt lgkmcnt(14)
  v_mfma_f32_16x16x32_bf16 v[24:27], v[144:147], v[72:75], v[24:27]
  ds_read_b128 v[80:83], v176 offset:0
  v_fma_f32 v65, v65, s40, -v251
  v_fma_f32 v66, v66, s40, -v251
  v_mfma_f32_16x16x32_bf16 v[28:31], v[148:151], v[72:75], v[28:31]
  ds_read_b128 v[84:87], v177 offset:0
  v_fma_f32 v67, v67, s40, -v251
  v_exp_f32 v64, v64
  v_mfma_f32_16x16x32_bf16 v[32:35], v[152:155], v[72:75], v[32:35]
  ds_read_b128 v[88:91], v178 offset:0
  v_exp_f32 v65, v65
  v_exp_f32 v66, v66
  v_mfma_f32_16x16x32_bf16 v[36:39], v[156:159], v[72:75], v[36:39]
  ds_read_b128 v[92:95], v179 offset:0
  v_exp_f32 v67, v67
  v_fma_f32 v68, v68, s40, -v251
  v_mfma_f32_16x16x32_bf16 v[40:43], v[160:163], v[72:75], v[40:43]
  ds_read_b128 v[96:99], v176 offset:4096
  v_fma_f32 v69, v69, s40, -v251
  v_fma_f32 v70, v70, s40, -v251
  v_mfma_f32_16x16x32_bf16 v[44:47], v[164:167], v[72:75], v[44:47]
  ds_read_b128 v[100:103], v177 offset:4096
  v_fma_f32 v71, v71, s40, -v251
  v_exp_f32 v68, v68
  v_mfma_f32_16x16x32_bf16 v[48:51], v[168:171], v[72:75], v[48:51]
  ds_read_b128 v[104:107], v178 offset:4096
  v_exp_f32 v69, v69
  v_exp_f32 v70, v70
  v_mfma_f32_16x16x32_bf16 v[52:55], v[172:175], v[72:75], v[52:55]
  ds_read_b128 v[108:111], v179 offset:4096
  v_exp_f32 v71, v71
  v_cvt_pk_bf16_f32 v76, v64, v65
  v_mfma_f32_16x16x32_bf16 v[240:243], v[244:247], v[72:75], v[240:243]
  v_cvt_pk_bf16_f32 v77, v66, v67
  v_cvt_pk_bf16_f32 v78, v68, v69
  v_cvt_pk_bf16_f32 v79, v70, v71
  s_waitcnt lgkmcnt(8)
  s_mov_b64 exec, 1
  ds_write_b32 v252, v248
  s_mov_b64 exec, -1
  v_min_u32 v249, v0, v1
  v_mfma_f32_16x16x32_bf16 v[240:243], v[244:247], v[76:79], v[240:243]
  v_readfirstlane_b32 s74, v249
  v_mfma_f32_16x16x32_bf16 v[24:27], v[112:115], v[76:79], v[24:27]
  ds_read_b128 v[112:115], v176 offset:8192
  v_add_u32 v180, s41, v180
  v_mfma_f32_16x16x32_bf16 v[28:31], v[116:119], v[76:79], v[28:31]
  ds_read_b128 v[116:119], v177 offset:8192
  v_add_u32 v181, s41, v181
  v_mfma_f32_16x16x32_bf16 v[32:35], v[120:123], v[76:79], v[32:35]
  ds_read_b128 v[120:123], v178 offset:8192
  v_add_u32 v182, s41, v182
  v_mfma_f32_16x16x32_bf16 v[36:39], v[124:127], v[76:79], v[36:39]
  ds_read_b128 v[124:127], v179 offset:8192
  v_add_u32 v183, s41, v183
  v_mfma_f32_16x16x32_bf16 v[40:43], v[128:131], v[76:79], v[40:43]
  ds_read_b128 v[128:131], v176 offset:12288
  v_add_u32 v184, s41, v184
  v_mfma_f32_16x16x32_bf16 v[44:47], v[132:135], v[76:79], v[44:47]
  ds_read_b128 v[132:135], v177 offset:12288
  v_add_u32 v185, s41, v185
  v_mfma_f32_16x16x32_bf16 v[48:51], v[136:139], v[76:79], v[48:51]
  ds_read_b128 v[136:139], v178 offset:12288
  v_add_u32 v186, s41, v186
  v_mfma_f32_16x16x32_bf16 v[52:55], v[140:143], v[76:79], v[52:55]
  ds_read_b128 v[140:143], v179 offset:12288
  v_add_u32 v187, s41, v187
C_END:
  s_and_b32 s68, s44, 48
  s_cbranch_scc1 C_SLOWEND
C_TAIL:
  s_cmp_lt_u32 s75, s74
  s_cbranch_scc1 C_GO
  s_branch C_LOOP
C_RESC:
  v_mov_b32 v249, v248
  s_nop 1
  v_permlane16_swap_b32 v248, v249
  s_nop 0
  v_max_f32 v248, v248, v249
  v_mov_b32 v249, v248
  s_nop 1
  v_permlane32_swap_b32 v248, v249
  s_nop 0
  v_max3_f32 v248, v248, v249, v253
  v_sub_f32 v250, v253, v248
  v_mul_f32 v250, s40, v250
  v_mov_b32 v253, v248
  v_exp_f32 v250, v250
  v_mul_f32 v251, s40, v248
  v_mul_f32 v240, v240, v250
  v_mul_f32 v24, v24, v250
  v_mul_f32 v25, v25, v250
  v_mul_f32 v26, v26, v250
  v_mul_f32 v27, v27, v250
  v_mul_f32 v28, v28, v250
  v_mul_f32 v29, v29, v250
  v_mul_f32 v30, v30, v250
  v_mul_f32 v31, v31, v250
  v_mul_f32 v32, v32, v250
  v_mul_f32 v33, v33, v250
  v_mul_f32 v34, v34, v250
  v_mul_f32 v35, v35, v250
  v_mul_f32 v36, v36, v250
  v_mul_f32 v37, v37, v250
  v_mul_f32 v38, v38, v250
  v_mul_f32 v39, v39, v250
  v_mul_f32 v40, v40, v250
  v_mul_f32 v41, v41, v250
  v_mul_f32 v42, v42, v250
  v_mul_f32 v43, v43, v250
  v_mul_f32 v44, v44, v250
  v_mul_f32 v45, v45, v250
  v_mul_f32 v46, v46, v250
  v_mul_f32 v47, v47, v250
  v_mul_f32 v48, v48, v250
  v_mul_f32 v49, v49, v250
  v_mul_f32 v50, v50, v250
  v_mul_f32 v51, v51, v250
  v_mul_f32 v52, v52, v250
  v_mul_f32 v53, v53, v250
  v_mul_f32 v54, v54, v250
  v_mul_f32 v55, v55, v250
  s_branch C_NORESC
C_MASK:
  v_readfirstlane_b32 s46, v6
  v_mbcnt_lo_u32_b32 v249, -1, 0
  v_mbcnt_hi_u32_b32 v249, -1, v249
  v_lshrrev_b32 v249, 4, v249
  v_lshlrev_b32 v249, 2, v249
  v_mov_b32 v248, 0xd0000000
  s_nop 1
  s_sub_i32 s68, s46, 0
  v_cmp_gt_i32 vcc, s68, v249
  s_nop 1
  v_cndmask_b32 v56, v248, v56, vcc
  s_sub_i32 s68, s46, 1
  v_cmp_gt_i32 vcc, s68, v249
  s_nop 1
  v_cndmask_b32 v57, v248, v57, vcc
  s_sub_i32 s68, s46, 2
  v_cmp_gt_i32 vcc, s68, v249
  s_nop 1
  v_cndmask_b32 v58, v248, v58, vcc
  s_sub_i32 s68, s46, 3
  v_cmp_gt_i32 vcc, s68, v249
  s_nop 1
  v_cndmask_b32 v59, v248, v59, vcc
  s_sub_i32 s68, s46, 16
  v_cmp_gt_i32 vcc, s68, v249
  s_nop 1
  v_cndmask_b32 v60, v248, v60, vcc
  s_sub_i32 s68, s46, 17
  v_cmp_gt_i32 vcc, s68, v249
  s_nop 1
  v_cndmask_b32 v61, v248, v61, vcc
  s_sub_i32 s68, s46, 18
  v_cmp_gt_i32 vcc, s68, v249
  s_nop 1
  v_cndmask_b32 v62, v248, v62, vcc
  s_sub_i32 s68, s46, 19
  v_cmp_gt_i32 vcc, s68, v249
  s_nop 1
  v_cndmask_b32 v63, v248, v63, vcc
  s_sub_i32 s68, s46, 32
  v_cmp_gt_i32 vcc, s68, v249
  s_nop 1
  v_cndmask_b32 v64, v248, v64, vcc
  s_sub_i32 s68, s46, 33
  v_cmp_gt_i32 vcc, s68, v249
  s_nop 1
  v_cndmask_b32 v65, v248, v65, vcc
  s_sub_i32 s68, s46, 34
  v_cmp_gt_i32 vcc, s68, v249
  s_nop 1
  v_cndmask_b32 v66, v248, v66, vcc
  s_sub_i32 s68, s46, 35
  v_cmp_gt_i32 vcc, s68, v249
  s_nop 1
  v_cndmask_b32 v67, v248, v67, vcc
  s_sub_i32 s68, s46, 48
  v_cmp_gt_i32 vcc, s68, v249
  s_nop 1
  v_cndmask_b32 v68, v248, v68, vcc
  s_sub_i32 s68, s46, 49
  v_cmp_gt_i32 vcc, s68, v249
  s_nop 1
  v_cndmask_b32 v69, v248, v69, vcc
  s_sub_i32 s68, s46, 50
  v_cmp_gt_i32 vcc, s68, v249
  s_nop 1
  v_cndmask_b32 v70, v248, v70, vcc
  s_sub_i32 s68, s46, 51
  v_cmp_gt_i32 vcc, s68, v249
  s_nop 1
  v_cndmask_b32 v71, v248, v71, vcc
  s_branch C_MASKED
C_SEG:
  v_readfirstlane_b32 s45, v5
  v_readfirstlane_b32 s47, v7
  s_bitcmp1_b32 s44, 9
  s_cbranch_scc0 C_SEG0
  s_mov_b32 s76, s47
  s_and_b32 s68, s76, 0xffff
  s_lshl_b32 s68, s68, 12
  s_add_u32 s68, s68, s61
  v_mbcnt_lo_u32_b32 v248, -1, 0
  v_mbcnt_hi_u32_b32 v248, -1, v248
  v_and_b32 v249, 15, v248
  v_lshrrev_b32 v248, 4, v248
  v_lshlrev_b32 v249, 8, v249
  v_lshl_add_u32 v249, v248, 4, v249
  buffer_load_dwordx4 v[224:227], v249, s[24:27], s68 offen offset:0
  buffer_load_dwordx4 v[228:231], v249, s[24:27], s68 offen offset:64
  buffer_load_dwordx4 v[232:235], v249, s[24:27], s68 offen offset:128
  buffer_load_dwordx4 v[236:239], v249, s[24:27], s68 offen offset:192
C_SEG0:
  s_and_b32 s68, s44, 70
  s_cbranch_scc0 C_SEG4
  s_waitcnt vmcnt(0)
  s_bitcmp1_b32 s44, 2
  s_cbranch_scc0 C_SEG3
  s_and_b32 s55, s55, 0xffff
  s_bitcmp1_b32 s44, 6
  s_cbranch_scc1 C_FLUSH
  s_cmp_eq_u32 s63, 2
  s_cbranch_scc1 C_FLUSH
  s_cmp_eq_u32 s63, 0
  s_cbranch_scc0 C_KEEP1
  v_cvt_pk_bf16_f32 v188, v24, v25
  v_cvt_pk_bf16_f32 v189, v26, v27
  v_cvt_pk_bf16_f32 v190, v28, v29
  v_cvt_pk_bf16_f32 v191, v30, v31
  v_cvt_pk_bf16_f32 v192, v32, v33
  v_cvt_pk_bf16_f32 v193, v34, v35
  v_cvt_pk_bf16_f32 v194, v36, v37
  v_cvt_pk_bf16_f32 v195, v38, v39
  v_cvt_pk_bf16_f32 v196, v40, v41
  v_cvt_pk_bf16_f32 v197, v42, v43
  v_cvt_pk_bf16_f32 v198, v44, v45
  v_cvt_pk_bf16_f32 v199, v46, v47
  v_cvt_pk_bf16_f32 v200, v48, v49
  v_cvt_pk_bf16_f32 v201, v50, v51
  v_cvt_pk_bf16_f32 v202, v52, v53
  v_cvt_pk_bf16_f32 v203, v54, v55
  v_mov_b32 v204, v253
  v_mov_b32 v205, v240
  s_mov_b32 s56, s55
  s_mov_b32 s63, 1
  s_branch C_SEG3
C_KEEP1:
  v_cvt_pk_bf16_f32 v206, v24, v25
  v_cvt_pk_bf16_f32 v207, v26, v27
  v_cvt_pk_bf16_f32 v208, v28, v29
  v_cvt_pk_bf16_f32 v209, v30, v31
  v_cvt_pk_bf16_f32 v210, v32, v33
  v_cvt_pk_bf16_f32 v211, v34, v35
  v_cvt_pk_bf16_f32 v212, v36, v37
  v_cvt_pk_bf16_f32 v213, v38, v39
  v_cvt_pk_bf16_f32 v214, v40, v41
  v_cvt_pk_bf16_f32 v215, v42, v43
  v_cvt_pk_bf16_f32 v216, v44, v45
  v_cvt_pk_bf16_f32 v217, v46, v47
  v_cvt_pk_bf16_f32 v218, v48, v49
  v_cvt_pk_bf16_f32 v219, v50, v51
  v_cvt_pk_bf16_f32 v220, v52, v53
  v_cvt_pk_bf16_f32 v221, v54, v55
  v_mov_b32 v222, v253
  v_mov_b32 v223, v240
  s_mov_b32 s57, s55
  s_mov_b32 s63, 2
  s_branch C_SEG3
C_FLUSH:
  s_mov_b32 s66, 1
C_FLUSH2:
  v_mbcnt_lo_u32_b32 v248, -1, 0
  v_mbcnt_hi_u32_b32 v248, -1, v248
  v_lshlrev_b32 v248, 4, v248
  v_lshrrev_b32 v249, 1, v248
  s_cmp_le_u32 s63, 0
  s_cbranch_scc1 C_FL1
  s_mul_i32 s68, s56, 18432
  s_add_u32 s68, s68, s62
  buffer_store_dwordx4 v[188:191], v248, s[36:39], s68 offen offset:0 sc1
  buffer_store_dwordx4 v[192:195], v248, s[36:39], s68 offen offset:1024 sc1
  buffer_store_dwordx4 v[196:199], v248, s[36:39], s68 offen offset:2048 sc1
  buffer_store_dwordx4 v[200:203], v248, s[36:39], s68 offen offset:3072 sc1
  s_add_u32 s68, s68, 4096
  buffer_store_dwordx2 v[204:205], v249, s[36:39], s68 offen sc1
  s_cmp_le_u32 s63, 1
  s_cbranch_scc1 C_FL1
  s_mul_i32 s68, s57, 18432
  s_add_u32 s68, s68, s62
  buffer_store_dwordx4 v[206:209], v248, s[36:39], s68 offen offset:0 sc1
  buffer_store_dwordx4 v[210:213], v248, s[36:39], s68 offen offset:1024 sc1
  buffer_store_dwordx4 v[214:217], v248, s[36:39], s68 offen offset:2048 sc1
  buffer_store_dwordx4 v[218:221], v248, s[36:39], s68 offen offset:3072 sc1
  s_add_u32 s68, s68, 4096
  buffer_store_dwordx2 v[222:223], v249, s[36:39], s68 offen sc1
C_FL1:
  s_cmp_eq_u32 s66, 0
  s_cbranch_scc1 C_FL4
  v_cvt_pk_bf16_f32 v144, v24, v25
  v_cvt_pk_bf16_f32 v145, v26, v27
  v_cvt_pk_bf16_f32 v146, v28, v29
  v_cvt_pk_bf16_f32 v147, v30, v31
  v_cvt_pk_bf16_f32 v148, v32, v33
  v_cvt_pk_bf16_f32 v149, v34, v35
  v_cvt_pk_bf16_f32 v150, v36, v37
  v_cvt_pk_bf16_f32 v151, v38, v39
  v_cvt_pk_bf16_f32 v152, v40, v41
  v_cvt_pk_bf16_f32 v153, v42, v43
  v_cvt_pk_bf16_f32 v154, v44, v45
  v_cvt_pk_bf16_f32 v155, v46, v47
  v_cvt_pk_bf16_f32 v156, v48, v49
  v_cvt_pk_bf16_f32 v157, v50, v51
  v_cvt_pk_bf16_f32 v158, v52, v53
  v_cvt_pk_bf16_f32 v159, v54, v55
  v_mov_b32 v160, v253
  v_mov_b32 v161, v240
  s_mul_i32 s68, s55, 18432
  s_add_u32 s68, s68, s62
  buffer_store_dwordx4 v[144:147], v248, s[36:39], s68 offen offset:0 sc1
  buffer_store_dwordx4 v[148:151], v248, s[36:39], s68 offen offset:1024 sc1
  buffer_store_dwordx4 v[152:155], v248, s[36:39], s68 offen offset:2048 sc1
  buffer_store_dwordx4 v[156:159], v248, s[36:39], s68 offen offset:3072 sc1
  s_add_u32 s68, s68, 4096
  buffer_store_dwordx2 v[160:161], v249, s[36:39], s68 offen sc1
C_FL4:
  v_mov_b32 v250, 1
  v_mov_b32 v248, s79
  s_add_u32 s79, s79, 4
  s_andn2_b32 s79, s79, 64
  s_or_b32 s79, s79, 32
  s_waitcnt vmcnt(0)
  s_mov_b64 exec, 1
  ds_add_rtn_u32 v250, v248, v250
  s_mov_b64 exec, -1
  s_waitcnt lgkmcnt(0)
  v_readfirstlane_b32 s68, v250
  s_and_b32 s68, s68, 3
  s_cmp_eq_u32 s68, 3
  s_cbranch_scc0 C_FL2
  s_cmp_eq_u32 s66, 0
  s_cbranch_scc1 C_FL5
  s_lshr_b32 s68, s55, 3
  s_andn2_b32 s68, s68, 3
  s_and_b32 s69, s55, 31
  s_lshl_b32 s70, 1, s69
  s_atomic_add s70, s[16:17], s68
C_FL5:
  s_cmp_le_u32 s63, 0
  s_cbranch_scc1 C_FL3
  s_lshr_b32 s68, s56, 3
  s_andn2_b32 s68, s68, 3
  s_and_b32 s69, s56, 31
  s_lshl_b32 s71, 1, s69
  s_atomic_add s71, s[16:17], s68
  s_cmp_le_u32 s63, 1
  s_cbranch_scc1 C_FL3
  s_lshr_b32 s68, s57, 3
  s_andn2_b32 s68, s68, 3
  s_and_b32 s69, s57, 31
  s_lshl_b32 s72, 1, s69
  s_atomic_add s72, s[16:17], s68
C_FL3:
  s_waitcnt lgkmcnt(0)
C_FL2:
  s_mov_b32 s63, 0
  s_cmp_eq_u32 s66, 0
  s_cbranch_scc1 C_CHK
C_SEG3:
  s_bitcmp1_b32 s44, 6
  s_cbranch_scc1 C_EXIT
  s_bitcmp1_b32 s44, 1
  s_cbranch_scc0 C_SEG4
  s_mov_b32 s54, s45
  s_mov_b32 s55, s47
  v_mov_b32 v24, 0
  v_mov_b32 v25, 0
  v_mov_b32 v26, 0
  v_mov_b32 v27, 0
  v_mov_b32 v28, 0
  v_mov_b32 v29, 0
  v_mov_b32 v30, 0
  v_mov_b32 v31, 0
  v_mov_b32 v32, 0
  v_mov_b32 v33, 0
  v_mov_b32 v34, 0
  v_mov_b32 v35, 0
  v_mov_b32 v36, 0
  v_mov_b32 v37, 0
  v_mov_b32 v38, 0
  v_mov_b32 v39, 0
  v_mov_b32 v40, 0
  v_mov_b32 v41, 0
  v_mov_b32 v42, 0
  v_mov_b32 v43, 0
  v_mov_b32 v44, 0
  v_mov_b32 v45, 0
  v_mov_b32 v46, 0
  v_mov_b32 v47, 0
  v_mov_b32 v48, 0
  v_mov_b32 v49, 0
  v_mov_b32 v50, 0
  v_mov_b32 v51, 0
  v_mov_b32 v52, 0
  v_mov_b32 v53, 0
  v_mov_b32 v54, 0
  v_mov_b32 v55, 0
  v_mov_b32 v253, 0xd3800000
  v_mov_b32 v240, 0
  v_mov_b32 v241, 0
  v_mov_b32 v242, 0
  v_mov_b32 v243, 0
  s_cmp_eq_u32 s45, s52
  s_cbranch_scc1 C_SEG4
  s_mov_b32 s52, s45
  s_cmp_eq_u32 s45, s76
  s_cbranch_scc1 C_QCOPY
  s_and_b32 s68, s52, 0xffff
  s_lshl_b32 s68, s68, 12
  s_add_u32 s68, s68, s61
  v_mbcnt_lo_u32_b32 v248, -1, 0
  v_mbcnt_hi_u32_b32 v248, -1, v248
  v_and_b32 v249, 15, v248
  v_lshrrev_b32 v248, 4, v248
  v_lshlrev_b32 v249, 8, v249
  v_lshl_add_u32 v249, v248, 4, v249
  buffer_load_dwordx4 v[8:11], v249, s[24:27], s68 offen offset:0
  buffer_load_dwordx4 v[12:15], v249, s[24:27], s68 offen offset:64
  buffer_load_dwordx4 v[16:19], v249, s[24:27], s68 offen offset:128
  buffer_load_dwordx4 v[20:23], v249, s[24:27], s68 offen offset:192
  s_waitcnt vmcnt(0)
  s_branch C_SEG4
C_QCOPY:
  v_mov_b32 v8, v224
  v_mov_b32 v9, v225
  v_mov_b32 v10, v226
  v_mov_b32 v11, v227
  v_mov_b32 v12, v228
  v_mov_b32 v13, v229
  v_mov_b32 v14, v230
  v_mov_b32 v15, v231
  v_mov_b32 v16, v232
  v_mov_b32 v17, v233
  v_mov_b32 v18, v234
  v_mov_b32 v19, v235
  v_mov_b32 v20, v236
  v_mov_b32 v21, v237
  v_mov_b32 v22, v238
  v_mov_b32 v23, v239
  s_mov_b32 s76, -1
C_SEG4:
  s_bitcmp1_b32 s44, 8
  s_cbranch_scc0 C_SEG5
  s_mov_b32 s66, 0
  s_cmp_eq_u32 s63, 0
  s_cbranch_scc0 C_FLUSH2
C_SEG5:
  s_branch C_CHK
C_EXIT:
  s_endpgm
C_SLOWEND:
  v_readfirstlane_b32 s60, v3
C_MSTEP:
  s_cmp_eq_u32 s58, 0
  s_cbranch_scc1 C_M2
  s_bitcmp1_b32 s44, 5
  s_cbranch_scc1 C_MERGE
  s_getreg_b32 s68, hwreg(HW_REG_IB_STS)
  s_and_b32 s68, s68, 0xc0000f
  s_cbranch_scc1 C_TAIL
  s_branch C_MERGE
C_M2:
  s_bitcmp1_b32 s44, 5
  s_cbranch_scc0 C_M3
  ds_read_b32 v249, v255 offset:12
  s_waitcnt lgkmcnt(0)
  v_readfirstlane_b32 s60, v249
C_M3:
  s_cmp_eq_u32 s58, 0
  s_cbranch_scc0 C_M4
  s_andn2_b32 s69, s60, s59
  s_cbranch_scc0 C_M4
  v_mbcnt_lo_u32_b32 v248, -1, 0
  v_mbcnt_hi_u32_b32 v248, -1, v248
  v_lshlrev_b32 v248, 4, v248
  v_lshrrev_b32 v249, 1, v248
  s_ff1_i32_b32 s69, s69
  s_bitset1_b32 s59, s69
  s_and_b32 s68, s55, 0xfff0
  s_add_u32 s68, s68, s69
  s_mul_i32 s68, s68, 18432
  s_add_u32 s68, s68, s62
  s_mov_b32 s58, 1
  buffer_load_dwordx4 v[188:191], v248, s[36:39], s68 offen offset:0 sc1
  buffer_load_dwordx4 v[192:195], v248, s[36:39], s68 offen offset:1024 sc1
  buffer_load_dwordx4 v[196:199], v248, s[36:39], s68 offen offset:2048 sc1
  buffer_load_dwordx4 v[200:203], v248, s[36:39], s68 offen offset:3072 sc1
  s_add_u32 s68, s68, 4096
  buffer_load_dwordx2 v[204:205], v249, s[36:39], s68 offen sc1
  s_andn2_b32 s69, s60, s59
  s_cbranch_scc0 C_M4
  s_ff1_i32_b32 s69, s69
  s_bitset1_b32 s59, s69
  s_and_b32 s68, s55, 0xfff0
  s_add_u32 s68, s68, s69
  s_mul_i32 s68, s68, 18432
  s_add_u32 s68, s68, s62
  s_mov_b32 s58, 2
  buffer_load_dwordx4 v[206:209], v248, s[36:39], s68 offen offset:0 sc1
  buffer_load_dwordx4 v[210:213], v248, s[36:39], s68 offen offset:1024 sc1
  buffer_load_dwordx4 v[214:217], v248, s[36:39], s68 offen offset:2048 sc1
  buffer_load_dwordx4 v[218:221], v248, s[36:39], s68 offen offset:3072 sc1
  s_add_u32 s68, s68, 4096
  buffer_load_dwordx2 v[222:223], v249, s[36:39], s68 offen sc1
  s_branch C_M4
C_M4:
  s_bitcmp1_b32 s44, 5
  s_cbranch_scc0 C_TAIL
  s_lshr_b32 s70, s55, 16
  s_cmp_eq_u32 s59, s70
  s_cbranch_scc0 C_MSTEP
  s_cmp_eq_u32 s58, 0
  s_cbranch_scc1 C_MDONE
  s_branch C_MSTEP
C_MERGE:
  s_nop 3
  s_waitcnt vmcnt(0)
  v_sub_f32 v250, v253, v204
  v_cmp_gt_f32 vcc, s43, v250
  s_cbranch_vccz C_MG0
  v_max_f32 v248, v253, v204
  v_sub_f32 v250, v253, v248
  v_mul_f32 v250, s40, v250
  v_exp_f32 v250, v250
  v_mov_b32 v253, v248
  v_mul_f32 v240, v240, v250
  v_mul_f32 v24, v24, v250
  v_mul_f32 v25, v25, v250
  v_mul_f32 v26, v26, v250
  v_mul_f32 v27, v27, v250
  v_mul_f32 v28, v28, v250
  v_mul_f32 v29, v29, v250
  v_mul_f32 v30, v30, v250
  v_mul_f32 v31, v31, v250
  v_mul_f32 v32, v32, v250
  v_mul_f32 v33, v33, v250
  v_mul_f32 v34, v34, v250
  v_mul_f32 v35, v35, v250
  v_mul_f32 v36, v36, v250
  v_mul_f32 v37, v37, v250
  v_mul_f32 v38, v38, v250
  v_mul_f32 v39, v39, v250
  v_mul_f32 v40, v40, v250
  v_mul_f32 v41, v41, v250
  v_mul_f32 v42, v42, v250
  v_mul_f32 v43, v43, v250
  v_mul_f32 v44, v44, v250
  v_mul_f32 v45, v45, v250
  v_mul_f32 v46, v46, v250
  v_mul_f32 v47, v47, v250
  v_mul_f32 v48, v48, v250
  v_mul_f32 v49, v49, v250
  v_mul_f32 v50, v50, v250
  v_mul_f32 v51, v51, v250
  v_mul_f32 v52, v52, v250
  v_mul_f32 v53, v53, v250
  v_mul_f32 v54, v54, v250
  v_mul_f32 v55, v55, v250
C_MG0:
  v_sub_f32 v251, v204, v253
  v_mul_f32 v251, s40, v251
  v_exp_f32 v251, v251
  v_lshlrev_b32 v249, 16, v188
  v_fmac_f32 v240, v205, v251
  v_and_b32 v248, 0xffff0000, v188
  v_fmac_f32 v24, v249, v251
  v_fmac_f32 v25, v248, v251
  v_lshlrev_b32 v249, 16, v189
  v_and_b32 v248, 0xffff0000, v189
  v_fmac_f32 v26, v249, v251
  v_fmac_f32 v27, v248, v251
  v_lshlrev_b32 v249, 16, v190
  v_and_b32 v248, 0xffff0000, v190
  v_fmac_f32 v28, v249, v251
  v_fmac_f32 v29, v248, v251
  v_lshlrev_b32 v249, 16, v191
  v_and_b32 v248, 0xffff0000, v191
  v_fmac_f32 v30, v249, v251
  v_fmac_f32 v31, v248, v251
  v_lshlrev_b32 v249, 16, v192
  v_and_b32 v248, 0xffff0000, v192
  v_fmac_f32 v32, v249, v251
  v_fmac_f32 v33, v248, v251
  v_lshlrev_b32 v249, 16, v193
  v_and_b32 v248, 0xffff0000, v193
  v_fmac_f32 v34, v249, v251
  v_fmac_f32 v35, v248, v251
  v_lshlrev_b32 v249, 16, v194
  v_and_b32 v248, 0xffff0000, v194
  v_fmac_f32 v36, v249, v251
  v_fmac_f32 v37, v248, v251
  v_lshlrev_b32 v249, 16, v195
  v_and_b32 v248, 0xffff0000, v195
  v_fmac_f32 v38, v249, v251
  v_fmac_f32 v39, v248, v251
  v_lshlrev_b32 v249, 16, v196
  v_and_b32 v248, 0xffff0000, v196
  v_fmac_f32 v40, v249, v251
  v_fmac_f32 v41, v248, v251
  v_lshlrev_b32 v249, 16, v197
  v_and_b32 v248, 0xffff0000, v197
  v_fmac_f32 v42, v249, v251
  v_fmac_f32 v43, v248, v251
  v_lshlrev_b32 v249, 16, v198
  v_and_b32 v248, 0xffff0000, v198
  v_fmac_f32 v44, v249, v251
  v_fmac_f32 v45, v248, v251
  v_lshlrev_b32 v249, 16, v199
  v_and_b32 v248, 0xffff0000, v199
  v_fmac_f32 v46, v249, v251
  v_fmac_f32 v47, v248, v251
  v_lshlrev_b32 v249, 16, v200
  v_and_b32 v248, 0xffff0000, v200
  v_fmac_f32 v48, v249, v251
  v_fmac_f32 v49, v248, v251
  v_lshlrev_b32 v249, 16, v201
  v_and_b32 v248, 0xffff0000, v201
  v_fmac_f32 v50, v249, v251
  v_fmac_f32 v51, v248, v251
  v_lshlrev_b32 v249, 16, v202
  v_and_b32 v248, 0xffff0000, v202
  v_fmac_f32 v52, v249, v251
  v_fmac_f32 v53, v248, v251
  v_lshlrev_b32 v249, 16, v203
  v_and_b32 v248, 0xffff0000, v203
  v_fmac_f32 v54, v249, v251
  v_fmac_f32 v55, v248, v251
  s_cmp_le_u32 s58, 1
  s_cbranch_scc1 C_MERGED
  v_sub_f32 v250, v253, v222
  v_cmp_gt_f32 vcc, s43, v250
  s_cbranch_vccz C_MG1
  v_max_f32 v248, v253, v222
  v_sub_f32 v250, v253, v248
  v_mul_f32 v250, s40, v250
  v_exp_f32 v250, v250
  v_mov_b32 v253, v248
  v_mul_f32 v240, v240, v250
  v_mul_f32 v24, v24, v250
  v_mul_f32 v25, v25, v250
  v_mul_f32 v26, v26, v250
  v_mul_f32 v27, v27, v250
  v_mul_f32 v28, v28, v250
  v_mul_f32 v29, v29, v250
  v_mul_f32 v30, v30, v250
  v_mul_f32 v31, v31, v250
  v_mul_f32 v32, v32, v250
  v_mul_f32 v33, v33, v250
  v_mul_f32 v34, v34, v250
  v_mul_f32 v35, v35, v250
  v_mul_f32 v36, v36, v250
  v_mul_f32 v37, v37, v250
  v_mul_f32 v38, v38, v250
  v_mul_f32 v39, v39, v250
  v_mul_f32 v40, v40, v250
  v_mul_f32 v41, v41, v250
  v_mul_f32 v42, v42, v250
  v_mul_f32 v43, v43, v250
  v_mul_f32 v44, v44, v250
  v_mul_f32 v45, v45, v250
  v_mul_f32 v46, v46, v250
  v_mul_f32 v47, v47, v250
  v_mul_f32 v48, v48, v250
  v_mul_f32 v49, v49, v250
  v_mul_f32 v50, v50, v250
  v_mul_f32 v51, v51, v250
  v_mul_f32 v52, v52, v250
  v_mul_f32 v53, v53, v250
  v_mul_f32 v54, v54, v250
  v_mul_f32 v55, v55, v250
C_MG1:
  v_sub_f32 v251, v222, v253
  v_mul_f32 v251, s40, v251
  v_exp_f32 v251, v251
  v_lshlrev_b32 v249, 16, v206
  v_fmac_f32 v240, v223, v251
  v_and_b32 v248, 0xffff0000, v206
  v_fmac_f32 v24, v249, v251
  v_fmac_f32 v25, v248, v251
  v_lshlrev_b32 v249, 16, v207
  v_and_b32 v248, 0xffff0000, v207
  v_fmac_f32 v26, v249, v251
  v_fmac_f32 v27, v248, v251
  v_lshlrev_b32 v249, 16, v208
  v_and_b32 v248, 0xffff0000, v208
  v_fmac_f32 v28, v249, v251
  v_fmac_f32 v29, v248, v251
  v_lshlrev_b32 v249, 16, v209
  v_and_b32 v248, 0xffff0000, v209
  v_fmac_f32 v30, v249, v251
  v_fmac_f32 v31, v248, v251
  v_lshlrev_b32 v249, 16, v210
  v_and_b32 v248, 0xffff0000, v210
  v_fmac_f32 v32, v249, v251
  v_fmac_f32 v33, v248, v251
  v_lshlrev_b32 v249, 16, v211
  v_and_b32 v248, 0xffff0000, v211
  v_fmac_f32 v34, v249, v251
  v_fmac_f32 v35, v248, v251
  v_lshlrev_b32 v249, 16, v212
  v_and_b32 v248, 0xffff0000, v212
  v_fmac_f32 v36, v249, v251
  v_fmac_f32 v37, v248, v251
  v_lshlrev_b32 v249, 16, v213
  v_and_b32 v248, 0xffff0000, v213
  v_fmac_f32 v38, v249, v251
  v_fmac_f32 v39, v248, v251
  v_lshlrev_b32 v249, 16, v214
  v_and_b32 v248, 0xffff0000, v214
  v_fmac_f32 v40, v249, v251
  v_fmac_f32 v41, v248, v251
  v_lshlrev_b32 v249, 16, v215
  v_and_b32 v248, 0xffff0000, v215
  v_fmac_f32 v42, v249, v251
  v_fmac_f32 v43, v248, v251
  v_lshlrev_b32 v249, 16, v216
  v_and_b32 v248, 0xffff0000, v216
  v_fmac_f32 v44, v249, v251
  v_fmac_f32 v45, v248, v251
  v_lshlrev_b32 v249, 16, v217
  v_and_b32 v248, 0xffff0000, v217
  v_fmac_f32 v46, v249, v251
  v_fmac_f32 v47, v248, v251
  v_lshlrev_b32 v249, 16, v218
  v_and_b32 v248, 0xffff0000, v218
  v_fmac_f32 v48, v249, v251
  v_fmac_f32 v49, v248, v251
  v_lshlrev_b32 v249, 16, v219
  v_and_b32 v248, 0xffff0000, v219
  v_fmac_f32 v50, v249, v251
  v_fmac_f32 v51, v248, v251
  v_lshlrev_b32 v249, 16, v220
  v_and_b32 v248, 0xffff0000, v220
  v_fmac_f32 v52, v249, v251
  v_fmac_f32 v53, v248, v251
  v_lshlrev_b32 v249, 16, v221
  v_and_b32 v248, 0xffff0000, v221
  v_fmac_f32 v54, v249, v251
  v_fmac_f32 v55, v248, v251
C_MERGED:
  v_mul_f32 v251, s40, v253
  s_mov_b32 s58, 0
  s_branch C_M2
C_MDONE:
  s_nop 3
  v_rcp_f32 v250, v240
  v_mbcnt_lo_u32_b32 v248, -1, 0
  v_mbcnt_hi_u32_b32 v248, -1, v248
  v_and_b32 v249, 15, v248
  v_lshrrev_b32 v248, 4, v248
  v_lshlrev_b32 v249, 8, v249
  v_lshl_add_u32 v249, v248, 3, v249
  s_and_b32 s68, s54, 0xffff
  s_lshl_b32 s68, s68, 12
  s_add_u32 s68, s68, s61
  v_and_b32 v251, 1, v248
  v_mul_u32_u24 v251, 24, v251
  v_add_u32 v249, v249, v251
  v_mul_f32 v24, v24, v250
  v_mul_f32 v25, v25, v250
  v_mul_f32 v26, v26, v250
  v_mul_f32 v27, v27, v250
  v_mul_f32 v28, v28, v250
  v_mul_f32 v29, v29, v250
  v_mul_f32 v30, v30, v250
  v_mul_f32 v31, v31, v250
  v_cvt_pk_bf16_f32 v188, v24, v25
  v_cvt_pk_bf16_f32 v189, v26, v27
  v_cvt_pk_bf16_f32 v190, v28, v29
  v_cvt_pk_bf16_f32 v191, v30, v31
  s_nop 1
  v_permlane16_swap_b32 v188, v190
  v_permlane16_swap_b32 v189, v191
  buffer_store_dwordx4 v[188:191], v249, s[28:31], s68 offen offset:0
  v_mul_f32 v32, v32, v250
  v_mul_f32 v33, v33, v250
  v_mul_f32 v34, v34, v250
  v_mul_f32 v35, v35, v250
  v_mul_f32 v36, v36, v250
  v_mul_f32 v37, v37, v250
  v_mul_f32 v38, v38, v250
  v_mul_f32 v39, v39, v250
  v_cvt_pk_bf16_f32 v192, v32, v33
  v_cvt_pk_bf16_f32 v193, v34, v35
  v_cvt_pk_bf16_f32 v194, v36, v37
  v_cvt_pk_bf16_f32 v195, v38, v39
  s_nop 1
  v_permlane16_swap_b32 v192, v194
  v_permlane16_swap_b32 v193, v195
  buffer_store_dwordx4 v[192:195], v249, s[28:31], s68 offen offset:64
  v_mul_f32 v40, v40, v250
  v_mul_f32 v41, v41, v250
  v_mul_f32 v42, v42, v250
  v_mul_f32 v43, v43, v250
  v_mul_f32 v44, v44, v250
  v_mul_f32 v45, v45, v250
  v_mul_f32 v46, v46, v250
  v_mul_f32 v47, v47, v250
  v_cvt_pk_bf16_f32 v196, v40, v41
  v_cvt_pk_bf16_f32 v197, v42, v43
  v_cvt_pk_bf16_f32 v198, v44, v45
  v_cvt_pk_bf16_f32 v199, v46, v47
  s_nop 1
  v_permlane16_swap_b32 v196, v198
  v_permlane16_swap_b32 v197, v199
  buffer_store_dwordx4 v[196:199], v249, s[28:31], s68 offen offset:128
  v_mul_f32 v48, v48, v250
  v_mul_f32 v49, v49, v250
  v_mul_f32 v50, v50, v250
  v_mul_f32 v51, v51, v250
  v_mul_f32 v52, v52, v250
  v_mul_f32 v53, v53, v250
  v_mul_f32 v54, v54, v250
  v_mul_f32 v55, v55, v250
  v_cvt_pk_bf16_f32 v200, v48, v49
  v_cvt_pk_bf16_f32 v201, v50, v51
  v_cvt_pk_bf16_f32 v202, v52, v53
  v_cvt_pk_bf16_f32 v203, v54, v55
  s_nop 1
  v_permlane16_swap_b32 v200, v202
  v_permlane16_swap_b32 v201, v203
  buffer_store_dwordx4 v[200:203], v249, s[28:31], s68 offen offset:192
  s_branch C_EXIT
L_END:
  s_endpgm
S_STOP:
  s_lshl_b32 s56, s47, 2
  s_or_b32 s56, s56, 64
  s_or_b32 s56, s56, 2048
  s_add_u32 s41, s41, 1
  v_mov_b32 v20, s56
  v_mov_b32 v18, s41
  s_mov_b64 exec, 1
  ds_write_b32 v25, v20
  ds_write_b32 v26, v18
  s_mov_b64 exec, -1
  s_waitcnt vmcnt(0) lgkmcnt(0)
  s_cmp_lg_u32 s50, 0
  s_cbranch_scc1 S_POLL0
  s_barrier
S_POLL0:
  s_lshr_b32 s58, s45, 16
  s_cmp_eq_u32 s58, 0
  s_cbranch_scc1 S_EXIT
  s_sub_i32 s59, s41, 4
  s_lshr_b32 s60, s44, 16
  s_lshl_b32 s61, s60, 4
  s_and_b32 s61, s61, 16
  s_lshl_b32 s60, s60, 1
  s_andn2_b32 s60, s60, 3
  s_mov_b32 s62, 0
S_GATE:
  s_sleep 8
  ds_read_b32 v15, v26 offset:8
  s_waitcnt lgkmcnt(0)
  v_readfirstlane_b32 s56, v15
  s_cmp_lt_i32 s56, s59
  s_cbranch_scc1 S_GATE
S_POLL:
  s_load_dword s56, s[16:17], s60 glc
  s_waitcnt lgkmcnt(0)
  s_lshr_b32 s56, s56, s61
  s_and_b32 s56, s56, s58
  s_cmp_eq_u32 s56, s62
  s_cbranch_scc1 S_POLL2
  s_mov_b32 s62, s56
  v_mov_b32 v15, s56
  s_mov_b64 exec, 1
  ds_write_b32 v26, v15 offset:4
  s_mov_b64 exec, -1
  s_waitcnt lgkmcnt(0)
  s_cmp_eq_u32 s56, s58
  s_cbranch_scc1 S_EXIT
S_POLL2:
  s_sleep 30
  s_branch S_POLL
S_EXIT:
  s_endpgm
.section .rodata,"a"
.p2align 6
.amdhsa_kernel standalone__paged_block_table_kv_pagedattention__sampling_kernel
  .amdhsa_next_free_vgpr 256
  .amdhsa_next_free_sgpr 80
  .amdhsa_accum_offset 256
  .amdhsa_group_segment_fixed_size 0
  .amdhsa_kernarg_size 64
  .amdhsa_user_sgpr_count 2
  .amdhsa_user_sgpr_kernarg_segment_ptr 1
  .amdhsa_system_sgpr_workgroup_id_x 1
.end_amdhsa_kernel
```
